```python
import torch

def _softmax(x, axis=-1):
    return torch.softmax(x, dim=axis)
def _gelu(x):
    return torch.nn.functional.gelu(x, approximate="tanh")
def _silu(x):
    return torch.nn.functional.silu(x)
def _sigmoid(x):
    return torch.sigmoid(x)
def _layernorm(x, axis=-1, eps=1e-5):
    m = x.mean(dim=axis, keepdim=True)
    v = x.var(dim=axis, keepdim=True, unbiased=False)
    return (x - m) / torch.sqrt(v + eps)
def _scatter_add(tgt, idx, src, axis=0):
    return tgt.clone().index_add_(axis, idx, src)
def _segment_sum(src, seg, n):
    out = torch.zeros((n,) + src.shape[1:], dtype=src.dtype)
    return out.index_add_(0, seg, src)
def _pad(x, pw):
    flat = tuple(v for pair in reversed(pw) for v in pair)
    return torch.nn.functional.pad(x, flat)

kernel_name = 'standalone__low_rank_proj_linformer__decode'

def setup_inputs():

    _w = (lambda a: (lambda t: t.to(torch.bfloat16) if t.is_floating_point() else t)(torch.as_tensor(a)))
    B, H, Sq, Skv, Dh, R = 2, 16, 1, 8192, 256, 16
    return {
        "q": _w((lambda *s: torch.randn(*s, dtype=torch.bfloat16) * 0.8)(B, H, Sq, Dh)),
        "k": _w((lambda *s: torch.randn(*s, dtype=torch.bfloat16) * 0.8)(B, H, Skv, Dh)),
        "v": _w((lambda *s: torch.randn(*s, dtype=torch.bfloat16) * 0.05)(B, H, Skv, Dh)),
        "e_proj": _w((lambda *s: torch.randn(*s, dtype=torch.bfloat16) * 0.8)(R, Skv) * (Skv ** -0.5)),
        "f_proj": _w((lambda *s: torch.randn(*s, dtype=torch.bfloat16) * 0.05)(R, Skv) * (Skv ** -0.5)),
    }

def reference(q, k, v, e_proj, f_proj):
    B, H, Sq, Dh = q.shape
    kp = torch.einsum("rn,bhnd->bhrd", e_proj, k)
    vp = torch.einsum("rn,bhnd->bhrd", f_proj, v)
    scores = torch.einsum("bhqd,bhrd->bhqr", q, kp) * (Dh ** -0.5)
    p = _softmax(scores, axis=-1)
    o = torch.einsum("bhqr,bhrd->bhqd", p, vp)
    return o
```

```asm
; @launch grid=(256,1,1) block=(128,1,1) lds=1152
.amdgcn_target "amdgcn-amd-amdhsa--gfx950"
.text
.globl standalone__low_rank_proj_linformer__decode_kernel
.p2align 8
.type standalone__low_rank_proj_linformer__decode_kernel,@function
standalone__low_rank_proj_linformer__decode_kernel:
  s_cmp_ge_u32 s2, 0x100
  s_cbranch_scc1 L_end
  s_load_dwordx16 s[4:19], s[0:1], 0
  v_and_b32 v4, 63, v0
  v_and_b32 v5, 15, v0
  v_readfirstlane_b32 s56, v0
  s_and_b32 s55, s2, 7
  s_lshr_b32 s54, s2, 3
  v_lshrrev_b32 v6, 4, v4
  v_lshlrev_b32 v1, 12, v6
  v_lshl_add_u32 v1, v5, 4, v1
  v_lshlrev_b32 v2, 14, v5
  v_lshlrev_b32 v7, 4, v6
  v_add_u32 v2, v2, v7
  s_lshl_b32 s57, s54, 22
  s_lshr_b32 s3, s55, 1
  s_and_b32 s3, s3, 2
  s_xor_b32 s3, s3, s55
  s_lshl_b32 s62, s3, 5
  s_mov_b32 s22, 0x400000
  s_mov_b32 s23, 0x20000
  s_mov_b32 s30, 0x40000
  s_mov_b32 s31, 0x20000
  s_and_b32 s32, s62, 32
  s_lshr_b32 s32, s32, 4
  s_and_b32 s33, s62, 66
  s_lshr_b32 s33, s33, 1
  s_or_b32 s32, s32, s33
  s_and_b32 s33, s62, 128
  s_or_b32 s32, s32, s33
  s_and_b32 s33, s62, 12
  s_lshl_b32 s33, s33, 1
  s_or_b32 s32, s32, s33
  s_and_b32 s33, s62, 17
  s_lshl_b32 s33, s33, 2
  s_or_b32 s32, s32, s33
  s_lshl_b32 s59, s32, 14
  s_lshl_b32 s60, s32, 6
  s_mul_i32 s26, s54, 1024
  s_sub_u32 s55, s55, s54
  s_and_b32 s55, s55, 7
  s_lshl3_add_u32 s24, s54, s55
  s_lshl_b32 s24, s24, 10
  s_add_u32 s24, s24, 65536
  s_mov_b32 s42, 327680
  s_mov_b32 s43, 0x20000
  s_cmp_ge_u32 s56, 64
  s_cbranch_scc0 L_nocpf
  s_getpc_b64 s[46:47]
L_pc:
  v_lshlrev_b32 v40, 7, v4
  v_min_u32 v40, L_end-L_pc, v40
  global_load_dword v41, v40, s[46:47]
L_nocpf:
  s_waitcnt lgkmcnt(0)
  s_cbranch_scc1 L_helper
  s_add_u32 s20, s6, s57
  s_addc_u32 s21, s7, 0
  s_mov_b32 s28, s10
  s_mov_b32 s29, s11
  buffer_load_dwordx4 v[128:131], v1, s[20:23], s59 offen offset:0 nt
  buffer_load_dwordx4 v[136:139], v1, s[20:23], s59 offen offset:512 nt
  buffer_load_dwordx4 v[144:147], v1, s[20:23], s59 offen offset:1024 nt
  buffer_load_dwordx4 v[152:155], v1, s[20:23], s59 offen offset:1536 nt
  buffer_load_dwordx4 v[160:163], v1, s[20:23], s59 offen offset:2048 nt
  buffer_load_dwordx4 v[168:171], v1, s[20:23], s59 offen offset:2560 nt
  buffer_load_dwordx4 v[176:179], v1, s[20:23], s59 offen offset:3072 nt
  buffer_load_dwordx4 v[184:187], v1, s[20:23], s59 offen offset:3584 nt
  buffer_load_dwordx4 v[16:19], v2, s[28:31], s60 offen
  buffer_load_dwordx4 v[132:135], v1, s[20:23], s59 offen offset:256 nt
  buffer_load_dwordx4 v[140:143], v1, s[20:23], s59 offen offset:768 nt
  buffer_load_dwordx4 v[148:151], v1, s[20:23], s59 offen offset:1280 nt
  buffer_load_dwordx4 v[156:159], v1, s[20:23], s59 offen offset:1792 nt
  buffer_load_dwordx4 v[164:167], v1, s[20:23], s59 offen offset:2304 nt
  buffer_load_dwordx4 v[172:175], v1, s[20:23], s59 offen offset:2816 nt
  buffer_load_dwordx4 v[180:183], v1, s[20:23], s59 offen offset:3328 nt
  buffer_load_dwordx4 v[188:191], v1, s[20:23], s59 offen offset:3840 nt
  s_add_u32 s59, s59, 65536
  s_add_u32 s60, s60, 256
  buffer_load_dwordx4 v[192:195], v1, s[20:23], s59 offen offset:0 nt
  buffer_load_dwordx4 v[200:203], v1, s[20:23], s59 offen offset:512 nt
  buffer_load_dwordx4 v[208:211], v1, s[20:23], s59 offen offset:1024 nt
  buffer_load_dwordx4 v[216:219], v1, s[20:23], s59 offen offset:1536 nt
  buffer_load_dwordx4 v[224:227], v1, s[20:23], s59 offen offset:2048 nt
  buffer_load_dwordx4 v[232:235], v1, s[20:23], s59 offen offset:2560 nt
  buffer_load_dwordx4 v[240:243], v1, s[20:23], s59 offen offset:3072 nt
  buffer_load_dwordx4 v[248:251], v1, s[20:23], s59 offen offset:3584 nt
  buffer_load_dwordx4 v[20:23], v2, s[28:31], s60 offen
  buffer_load_dwordx4 v[196:199], v1, s[20:23], s59 offen offset:256 nt
  buffer_load_dwordx4 v[204:207], v1, s[20:23], s59 offen offset:768 nt
  buffer_load_dwordx4 v[212:215], v1, s[20:23], s59 offen offset:1280 nt
  buffer_load_dwordx4 v[220:223], v1, s[20:23], s59 offen offset:1792 nt
  buffer_load_dwordx4 v[228:231], v1, s[20:23], s59 offen offset:2304 nt
  buffer_load_dwordx4 v[236:239], v1, s[20:23], s59 offen offset:2816 nt
  buffer_load_dwordx4 v[244:247], v1, s[20:23], s59 offen offset:3328 nt
  buffer_load_dwordx4 v[252:255], v1, s[20:23], s59 offen offset:3840 nt
  s_mov_b32 s36, s4
  s_mov_b32 s37, s5
  s_mov_b32 s38, 0x4000
  s_mov_b32 s39, 0x20000
  s_lshl_b32 s3, s54, 9
  v_lshlrev_b32 v48, 4, v5
  buffer_load_dwordx4 v[8:11], v48, s[36:39], s3 offen
  buffer_load_dwordx4 v[12:15], v48, s[36:39], s3 offen offset:256
  s_add_u32 s64, s8, s57
  s_addc_u32 s65, s9, 0
  s_mov_b32 s52, 0x05040100
  s_mov_b32 s53, 0x07060302
  s_mov_b32 s58, 2
  s_mov_b32 s63, 0
  s_add_u32 s50, s18, s26
  s_addc_u32 s51, s19, 0
  s_mov_b32 s40, s18
  s_mov_b32 s41, s19
  v_lshlrev_b32 v52, 3, v6
  v_lshl_add_u32 v52, v5, 5, v52
  s_mov_b32 s47, 100
  v_mov_b64 v[64:65], 0
  v_mov_b64 v[66:67], 0
  v_mov_b64 v[68:69], 0
  v_mov_b64 v[70:71], 0
  v_mov_b64 v[72:73], 0
  v_mov_b64 v[74:75], 0
  v_mov_b64 v[76:77], 0
  v_mov_b64 v[78:79], 0
  v_mov_b64 v[80:81], 0
  v_mov_b64 v[82:83], 0
  v_mov_b64 v[84:85], 0
  v_mov_b64 v[86:87], 0
  v_mov_b64 v[88:89], 0
  v_mov_b64 v[90:91], 0
  v_mov_b64 v[92:93], 0
  v_mov_b64 v[94:95], 0
  v_mov_b64 v[96:97], 0
  v_mov_b64 v[98:99], 0
  v_mov_b64 v[100:101], 0
  v_mov_b64 v[102:103], 0
  v_mov_b64 v[104:105], 0
  v_mov_b64 v[106:107], 0
  v_mov_b64 v[108:109], 0
  v_mov_b64 v[110:111], 0
  v_mov_b64 v[112:113], 0
  v_mov_b64 v[114:115], 0
  v_mov_b64 v[116:117], 0
  v_mov_b64 v[118:119], 0
  v_mov_b64 v[120:121], 0
  v_mov_b64 v[122:123], 0
  v_mov_b64 v[124:125], 0
  v_mov_b64 v[126:127], 0
L_loop:
L_slot0:
  s_cmp_eq_u32 s58, 32
  s_cselect_b32 s20, s64, s20
  s_cselect_b32 s21, s65, s21
  s_cselect_b32 s28, s12, s28
  s_cselect_b32 s29, s13, s29
  s_and_b32 s3, s58, 31
  s_add_u32 s3, s3, s62
  s_cmp_lt_u32 s58, 61
  s_cbranch_scc1 L_map0
  s_cmp_lg_u32 s63, 0
  s_cbranch_scc1 L_last0
  s_cmp_lt_u32 s58, 62
  s_cbranch_scc1 L_draw0
  s_waitcnt lgkmcnt(0)
  s_add_u32 s61, s61, 1
  s_cmp_ge_u32 s61, 16
  s_cbranch_scc1 L_empty0
  s_and_b32 s3, s61, 7
  s_lshl_b32 s3, s3, 5
  s_lshr_b32 s32, s61, 3
  s_add_u32 s3, s3, s32
  s_add_u32 s3, s3, 30
L_draw0:
  s_mov_b32 s61, 1
  s_atomic_add s61, s[50:51], 64 glc
L_map0:
  s_and_b32 s32, s3, 32
  s_lshr_b32 s32, s32, 4
  s_and_b32 s33, s3, 66
  s_lshr_b32 s33, s33, 1
  s_or_b32 s32, s32, s33
  s_and_b32 s33, s3, 128
  s_or_b32 s32, s32, s33
  s_and_b32 s33, s3, 12
  s_lshl_b32 s33, s33, 1
  s_or_b32 s32, s32, s33
  s_and_b32 s33, s3, 17
  s_lshl_b32 s33, s33, 2
  s_or_b32 s32, s32, s33
  s_lshl_b32 s59, s32, 14
  s_lshl_b32 s60, s32, 6
L_mw00:
  s_getreg_b32 s48, hwreg(HW_REG_IB_STS)
  s_sub_i32 s47, s47, 3
  s_and_b32 s48, s48, 0xc0000f
  s_cmp_gt_u32 s48, 4194313
  s_cbranch_scc1 L_mw00
L_go0:
  s_waitcnt vmcnt(25)
  v_mov_b64 v[56:57], v[16:17]
  v_mov_b64 v[58:59], v[18:19]
  s_cmp_lg_u32 s63, 0
  v_perm_b32 v32, v136, v128, s52
  v_perm_b32 v33, v152, v144, s52
  v_perm_b32 v34, v168, v160, s52
  v_perm_b32 v35, v184, v176, s52
  v_perm_b32 v36, v136, v128, s53
  v_perm_b32 v37, v152, v144, s53
  v_perm_b32 v38, v168, v160, s53
  v_perm_b32 v39, v184, v176, s53
  v_mfma_f32_16x16x32_bf16 v[64:67], v[56:59], v[32:35], v[64:67]
  v_perm_b32 v40, v137, v129, s52
  v_perm_b32 v41, v153, v145, s52
  v_perm_b32 v42, v169, v161, s52
  v_perm_b32 v43, v185, v177, s52
  v_mfma_f32_16x16x32_bf16 v[68:71], v[56:59], v[36:39], v[68:71]
  v_perm_b32 v44, v137, v129, s53
  v_perm_b32 v45, v153, v145, s53
  v_perm_b32 v46, v169, v161, s53
  v_perm_b32 v47, v185, v177, s53
  v_mfma_f32_16x16x32_bf16 v[72:75], v[56:59], v[40:43], v[72:75]
  v_perm_b32 v32, v138, v130, s52
  v_perm_b32 v33, v154, v146, s52
  v_perm_b32 v34, v170, v162, s52
  v_perm_b32 v35, v186, v178, s52
  v_mfma_f32_16x16x32_bf16 v[76:79], v[56:59], v[44:47], v[76:79]
  v_perm_b32 v36, v138, v130, s53
  v_perm_b32 v37, v154, v146, s53
  v_perm_b32 v38, v170, v162, s53
  v_perm_b32 v39, v186, v178, s53
  v_mfma_f32_16x16x32_bf16 v[80:83], v[56:59], v[32:35], v[80:83]
  v_perm_b32 v40, v139, v131, s52
  v_perm_b32 v41, v155, v147, s52
  v_perm_b32 v42, v171, v163, s52
  v_perm_b32 v43, v187, v179, s52
  v_mfma_f32_16x16x32_bf16 v[84:87], v[56:59], v[36:39], v[84:87]
  v_perm_b32 v44, v139, v131, s53
  v_perm_b32 v45, v155, v147, s53
  v_perm_b32 v46, v171, v163, s53
  v_perm_b32 v47, v187, v179, s53
  v_mfma_f32_16x16x32_bf16 v[88:91], v[56:59], v[40:43], v[88:91]
  s_cbranch_scc1 L_x00
  v_mfma_f32_16x16x32_bf16 v[92:95], v[56:59], v[44:47], v[92:95]
  s_add_i32 s47, s47, 18
  s_min_i32 s47, s47, 26
  s_max_i32 s47, s47, -200
L_tw00:
  s_cmp_le_i32 s47, 0
  s_cbranch_scc1 L_td00
  s_getreg_b32 s48, hwreg(HW_REG_IB_STS)
  s_sub_i32 s47, s47, 4
  s_and_b32 s48, s48, 0xc0000f
  s_cmp_gt_u32 s48, 4194305
  s_cbranch_scc1 L_tw00
L_td00:
  buffer_load_dwordx4 v[16:19], v2, s[28:31], s60 offen
  buffer_load_dwordx4 v[128:131], v1, s[20:23], s59 offen offset:0 nt
  buffer_load_dwordx4 v[136:139], v1, s[20:23], s59 offen offset:512 nt
  buffer_load_dwordx4 v[144:147], v1, s[20:23], s59 offen offset:1024 nt
  buffer_load_dwordx4 v[152:155], v1, s[20:23], s59 offen offset:1536 nt
  buffer_load_dwordx4 v[160:163], v1, s[20:23], s59 offen offset:2048 nt
  buffer_load_dwordx4 v[168:171], v1, s[20:23], s59 offen offset:2560 nt
  buffer_load_dwordx4 v[176:179], v1, s[20:23], s59 offen offset:3072 nt
  buffer_load_dwordx4 v[184:187], v1, s[20:23], s59 offen offset:3584 nt
L_mw10:
  s_getreg_b32 s48, hwreg(HW_REG_IB_STS)
  s_sub_i32 s47, s47, 3
  s_and_b32 s48, s48, 0xc0000f
  s_cmp_gt_u32 s48, 4194314
  s_cbranch_scc1 L_mw10
L_h10:
  s_cmp_lg_u32 s63, 0
  s_waitcnt vmcnt(26)
  v_perm_b32 v32, v140, v132, s52
  v_perm_b32 v33, v156, v148, s52
  v_perm_b32 v34, v172, v164, s52
  v_perm_b32 v35, v188, v180, s52
  v_perm_b32 v36, v140, v132, s53
  v_perm_b32 v37, v156, v148, s53
  v_perm_b32 v38, v172, v164, s53
  v_perm_b32 v39, v188, v180, s53
  v_mfma_f32_16x16x32_bf16 v[96:99], v[56:59], v[32:35], v[96:99]
  v_perm_b32 v40, v141, v133, s52
  v_perm_b32 v41, v157, v149, s52
  v_perm_b32 v42, v173, v165, s52
  v_perm_b32 v43, v189, v181, s52
  v_mfma_f32_16x16x32_bf16 v[100:103], v[56:59], v[36:39], v[100:103]
  v_perm_b32 v44, v141, v133, s53
  v_perm_b32 v45, v157, v149, s53
  v_perm_b32 v46, v173, v165, s53
  v_perm_b32 v47, v189, v181, s53
  v_mfma_f32_16x16x32_bf16 v[104:107], v[56:59], v[40:43], v[104:107]
  v_perm_b32 v32, v142, v134, s52
  v_perm_b32 v33, v158, v150, s52
  v_perm_b32 v34, v174, v166, s52
  v_perm_b32 v35, v190, v182, s52
  v_mfma_f32_16x16x32_bf16 v[108:111], v[56:59], v[44:47], v[108:111]
  v_perm_b32 v36, v142, v134, s53
  v_perm_b32 v37, v158, v150, s53
  v_perm_b32 v38, v174, v166, s53
  v_perm_b32 v39, v190, v182, s53
  v_mfma_f32_16x16x32_bf16 v[112:115], v[56:59], v[32:35], v[112:115]
  v_perm_b32 v40, v143, v135, s52
  v_perm_b32 v41, v159, v151, s52
  v_perm_b32 v42, v175, v167, s52
  v_perm_b32 v43, v191, v183, s52
  v_mfma_f32_16x16x32_bf16 v[116:119], v[56:59], v[36:39], v[116:119]
  v_perm_b32 v44, v143, v135, s53
  v_perm_b32 v45, v159, v151, s53
  v_perm_b32 v46, v175, v167, s53
  v_perm_b32 v47, v191, v183, s53
  v_mfma_f32_16x16x32_bf16 v[120:123], v[56:59], v[40:43], v[120:123]
  s_cbranch_scc1 L_x10
  v_mfma_f32_16x16x32_bf16 v[124:127], v[56:59], v[44:47], v[124:127]
  s_add_i32 s47, s47, 18
  s_min_i32 s47, s47, 26
  s_max_i32 s47, s47, -200
L_tw10:
  s_cmp_le_i32 s47, 0
  s_cbranch_scc1 L_td10
  s_getreg_b32 s48, hwreg(HW_REG_IB_STS)
  s_sub_i32 s47, s47, 4
  s_and_b32 s48, s48, 0xc0000f
  s_cmp_gt_u32 s48, 4194305
  s_cbranch_scc1 L_tw10
L_td10:
  buffer_load_dwordx4 v[132:135], v1, s[20:23], s59 offen offset:256 nt
  buffer_load_dwordx4 v[140:143], v1, s[20:23], s59 offen offset:768 nt
  buffer_load_dwordx4 v[148:151], v1, s[20:23], s59 offen offset:1280 nt
  buffer_load_dwordx4 v[156:159], v1, s[20:23], s59 offen offset:1792 nt
  buffer_load_dwordx4 v[164:167], v1, s[20:23], s59 offen offset:2304 nt
  buffer_load_dwordx4 v[172:175], v1, s[20:23], s59 offen offset:2816 nt
  buffer_load_dwordx4 v[180:183], v1, s[20:23], s59 offen offset:3328 nt
  buffer_load_dwordx4 v[188:191], v1, s[20:23], s59 offen offset:3840 nt
  s_add_u32 s58, s58, 1
L_slot1:
  s_and_b32 s3, s58, 31
  s_add_u32 s3, s3, s62
  s_cmp_lt_u32 s58, 61
  s_cbranch_scc1 L_map1
  s_cmp_lg_u32 s63, 0
  s_cbranch_scc1 L_last1
  s_cmp_lt_u32 s58, 62
  s_cbranch_scc1 L_draw1
  s_waitcnt lgkmcnt(0)
  s_add_u32 s61, s61, 1
  s_cmp_ge_u32 s61, 16
  s_cbranch_scc1 L_empty1
  s_and_b32 s3, s61, 7
  s_lshl_b32 s3, s3, 5
  s_lshr_b32 s32, s61, 3
  s_add_u32 s3, s3, s32
  s_add_u32 s3, s3, 30
L_draw1:
  s_mov_b32 s61, 1
  s_atomic_add s61, s[50:51], 64 glc
L_map1:
  s_and_b32 s32, s3, 32
  s_lshr_b32 s32, s32, 4
  s_and_b32 s33, s3, 66
  s_lshr_b32 s33, s33, 1
  s_or_b32 s32, s32, s33
  s_and_b32 s33, s3, 128
  s_or_b32 s32, s32, s33
  s_and_b32 s33, s3, 12
  s_lshl_b32 s33, s33, 1
  s_or_b32 s32, s32, s33
  s_and_b32 s33, s3, 17
  s_lshl_b32 s33, s33, 2
  s_or_b32 s32, s32, s33
  s_lshl_b32 s59, s32, 14
  s_lshl_b32 s60, s32, 6
L_mw01:
  s_getreg_b32 s48, hwreg(HW_REG_IB_STS)
  s_sub_i32 s47, s47, 3
  s_and_b32 s48, s48, 0xc0000f
  s_cmp_gt_u32 s48, 4194313
  s_cbranch_scc1 L_mw01
L_go1:
  s_waitcnt vmcnt(25)
  v_mov_b64 v[56:57], v[20:21]
  v_mov_b64 v[58:59], v[22:23]
  s_cmp_lg_u32 s63, 0
  v_perm_b32 v32, v200, v192, s52
  v_perm_b32 v33, v216, v208, s52
  v_perm_b32 v34, v232, v224, s52
  v_perm_b32 v35, v248, v240, s52
  v_perm_b32 v36, v200, v192, s53
  v_perm_b32 v37, v216, v208, s53
  v_perm_b32 v38, v232, v224, s53
  v_perm_b32 v39, v248, v240, s53
  v_mfma_f32_16x16x32_bf16 v[64:67], v[56:59], v[32:35], v[64:67]
  v_perm_b32 v40, v201, v193, s52
  v_perm_b32 v41, v217, v209, s52
  v_perm_b32 v42, v233, v225, s52
  v_perm_b32 v43, v249, v241, s52
  v_mfma_f32_16x16x32_bf16 v[68:71], v[56:59], v[36:39], v[68:71]
  v_perm_b32 v44, v201, v193, s53
  v_perm_b32 v45, v217, v209, s53
  v_perm_b32 v46, v233, v225, s53
  v_perm_b32 v47, v249, v241, s53
  v_mfma_f32_16x16x32_bf16 v[72:75], v[56:59], v[40:43], v[72:75]
  v_perm_b32 v32, v202, v194, s52
  v_perm_b32 v33, v218, v210, s52
  v_perm_b32 v34, v234, v226, s52
  v_perm_b32 v35, v250, v242, s52
  v_mfma_f32_16x16x32_bf16 v[76:79], v[56:59], v[44:47], v[76:79]
  v_perm_b32 v36, v202, v194, s53
  v_perm_b32 v37, v218, v210, s53
  v_perm_b32 v38, v234, v226, s53
  v_perm_b32 v39, v250, v242, s53
  v_mfma_f32_16x16x32_bf16 v[80:83], v[56:59], v[32:35], v[80:83]
  v_perm_b32 v40, v203, v195, s52
  v_perm_b32 v41, v219, v211, s52
  v_perm_b32 v42, v235, v227, s52
  v_perm_b32 v43, v251, v243, s52
  v_mfma_f32_16x16x32_bf16 v[84:87], v[56:59], v[36:39], v[84:87]
  v_perm_b32 v44, v203, v195, s53
  v_perm_b32 v45, v219, v211, s53
  v_perm_b32 v46, v235, v227, s53
  v_perm_b32 v47, v251, v243, s53
  v_mfma_f32_16x16x32_bf16 v[88:91], v[56:59], v[40:43], v[88:91]
  s_cbranch_scc1 L_x01
  v_mfma_f32_16x16x32_bf16 v[92:95], v[56:59], v[44:47], v[92:95]
  s_cmp_eq_u32 s58, 33
  s_cbranch_scc1 L_k0
L_k0r:
  s_add_i32 s47, s47, 18
  s_min_i32 s47, s47, 26
  s_max_i32 s47, s47, -200
L_tw01:
  s_cmp_le_i32 s47, 0
  s_cbranch_scc1 L_td01
  s_getreg_b32 s48, hwreg(HW_REG_IB_STS)
  s_sub_i32 s47, s47, 4
  s_and_b32 s48, s48, 0xc0000f
  s_cmp_gt_u32 s48, 4194305
  s_cbranch_scc1 L_tw01
L_td01:
  buffer_load_dwordx4 v[20:23], v2, s[28:31], s60 offen
  buffer_load_dwordx4 v[192:195], v1, s[20:23], s59 offen offset:0 nt
  buffer_load_dwordx4 v[200:203], v1, s[20:23], s59 offen offset:512 nt
  buffer_load_dwordx4 v[208:211], v1, s[20:23], s59 offen offset:1024 nt
  buffer_load_dwordx4 v[216:219], v1, s[20:23], s59 offen offset:1536 nt
  buffer_load_dwordx4 v[224:227], v1, s[20:23], s59 offen offset:2048 nt
  buffer_load_dwordx4 v[232:235], v1, s[20:23], s59 offen offset:2560 nt
  buffer_load_dwordx4 v[240:243], v1, s[20:23], s59 offen offset:3072 nt
  buffer_load_dwordx4 v[248:251], v1, s[20:23], s59 offen offset:3584 nt
L_mw11:
  s_getreg_b32 s48, hwreg(HW_REG_IB_STS)
  s_sub_i32 s47, s47, 3
  s_and_b32 s48, s48, 0xc0000f
  s_cmp_gt_u32 s48, 4194314
  s_cbranch_scc1 L_mw11
L_h11:
  s_cmp_lg_u32 s63, 0
  s_waitcnt vmcnt(26)
  v_perm_b32 v32, v204, v196, s52
  v_perm_b32 v33, v220, v212, s52
  v_perm_b32 v34, v236, v228, s52
  v_perm_b32 v35, v252, v244, s52
  v_perm_b32 v36, v204, v196, s53
  v_perm_b32 v37, v220, v212, s53
  v_perm_b32 v38, v236, v228, s53
  v_perm_b32 v39, v252, v244, s53
  v_mfma_f32_16x16x32_bf16 v[96:99], v[56:59], v[32:35], v[96:99]
  v_perm_b32 v40, v205, v197, s52
  v_perm_b32 v41, v221, v213, s52
  v_perm_b32 v42, v237, v229, s52
  v_perm_b32 v43, v253, v245, s52
  v_mfma_f32_16x16x32_bf16 v[100:103], v[56:59], v[36:39], v[100:103]
  v_perm_b32 v44, v205, v197, s53
  v_perm_b32 v45, v221, v213, s53
  v_perm_b32 v46, v237, v229, s53
  v_perm_b32 v47, v253, v245, s53
  v_mfma_f32_16x16x32_bf16 v[104:107], v[56:59], v[40:43], v[104:107]
  v_perm_b32 v32, v206, v198, s52
  v_perm_b32 v33, v222, v214, s52
  v_perm_b32 v34, v238, v230, s52
  v_perm_b32 v35, v254, v246, s52
  v_mfma_f32_16x16x32_bf16 v[108:111], v[56:59], v[44:47], v[108:111]
  v_perm_b32 v36, v206, v198, s53
  v_perm_b32 v37, v222, v214, s53
  v_perm_b32 v38, v238, v230, s53
  v_perm_b32 v39, v254, v246, s53
  v_mfma_f32_16x16x32_bf16 v[112:115], v[56:59], v[32:35], v[112:115]
  v_perm_b32 v40, v207, v199, s52
  v_perm_b32 v41, v223, v215, s52
  v_perm_b32 v42, v239, v231, s52
  v_perm_b32 v43, v255, v247, s52
  v_mfma_f32_16x16x32_bf16 v[116:119], v[56:59], v[36:39], v[116:119]
  v_perm_b32 v44, v207, v199, s53
  v_perm_b32 v45, v223, v215, s53
  v_perm_b32 v46, v239, v231, s53
  v_perm_b32 v47, v255, v247, s53
  v_mfma_f32_16x16x32_bf16 v[120:123], v[56:59], v[40:43], v[120:123]
  s_cbranch_scc1 L_x11
  v_mfma_f32_16x16x32_bf16 v[124:127], v[56:59], v[44:47], v[124:127]
  s_cmp_eq_u32 s58, 33
  s_cbranch_scc1 L_k1
L_k1r:
  s_add_i32 s47, s47, 18
  s_min_i32 s47, s47, 26
  s_max_i32 s47, s47, -200
L_tw11:
  s_cmp_le_i32 s47, 0
  s_cbranch_scc1 L_td11
  s_getreg_b32 s48, hwreg(HW_REG_IB_STS)
  s_sub_i32 s47, s47, 4
  s_and_b32 s48, s48, 0xc0000f
  s_cmp_gt_u32 s48, 4194305
  s_cbranch_scc1 L_tw11
L_td11:
  buffer_load_dwordx4 v[196:199], v1, s[20:23], s59 offen offset:256 nt
  buffer_load_dwordx4 v[204:207], v1, s[20:23], s59 offen offset:768 nt
  buffer_load_dwordx4 v[212:215], v1, s[20:23], s59 offen offset:1280 nt
  buffer_load_dwordx4 v[220:223], v1, s[20:23], s59 offen offset:1792 nt
  buffer_load_dwordx4 v[228:231], v1, s[20:23], s59 offen offset:2304 nt
  buffer_load_dwordx4 v[236:239], v1, s[20:23], s59 offen offset:2816 nt
  buffer_load_dwordx4 v[244:247], v1, s[20:23], s59 offen offset:3328 nt
  buffer_load_dwordx4 v[252:255], v1, s[20:23], s59 offen offset:3840 nt
  s_add_u32 s58, s58, 1
  s_cmp_eq_u32 s58, 50
  s_cbranch_scc1 L_b2
  s_branch L_loop
L_k0:
  v_lshlrev_b32 v48, 16, v8
  v_pk_mul_f32 v[28:29], v[64:65], v[48:49] op_sel_hi:[1,0]
  v_pk_mul_f32 v[30:31], v[66:67], v[48:49] op_sel_hi:[1,0]
  v_and_b32 v50, 0xffff0000, v8
  v_pk_fma_f32 v[28:29], v[68:69], v[50:51], v[28:29] op_sel_hi:[1,0,1]
  v_pk_fma_f32 v[30:31], v[70:71], v[50:51], v[30:31] op_sel_hi:[1,0,1]
  v_lshlrev_b32 v48, 16, v9
  v_pk_fma_f32 v[28:29], v[72:73], v[48:49], v[28:29] op_sel_hi:[1,0,1]
  v_pk_fma_f32 v[30:31], v[74:75], v[48:49], v[30:31] op_sel_hi:[1,0,1]
  v_and_b32 v50, 0xffff0000, v9
  v_pk_fma_f32 v[28:29], v[76:77], v[50:51], v[28:29] op_sel_hi:[1,0,1]
  v_pk_fma_f32 v[30:31], v[78:79], v[50:51], v[30:31] op_sel_hi:[1,0,1]
  v_lshlrev_b32 v48, 16, v10
  v_pk_fma_f32 v[28:29], v[80:81], v[48:49], v[28:29] op_sel_hi:[1,0,1]
  v_pk_fma_f32 v[30:31], v[82:83], v[48:49], v[30:31] op_sel_hi:[1,0,1]
  v_and_b32 v50, 0xffff0000, v10
  v_pk_fma_f32 v[28:29], v[84:85], v[50:51], v[28:29] op_sel_hi:[1,0,1]
  v_pk_fma_f32 v[30:31], v[86:87], v[50:51], v[30:31] op_sel_hi:[1,0,1]
  v_lshlrev_b32 v48, 16, v11
  v_pk_fma_f32 v[28:29], v[88:89], v[48:49], v[28:29] op_sel_hi:[1,0,1]
  v_pk_fma_f32 v[30:31], v[90:91], v[48:49], v[30:31] op_sel_hi:[1,0,1]
  v_and_b32 v50, 0xffff0000, v11
  v_pk_fma_f32 v[28:29], v[92:93], v[50:51], v[28:29] op_sel_hi:[1,0,1]
  v_pk_fma_f32 v[30:31], v[94:95], v[50:51], v[30:31] op_sel_hi:[1,0,1]
  v_mov_b64 v[64:65], 0
  v_mov_b64 v[66:67], 0
  v_mov_b64 v[68:69], 0
  v_mov_b64 v[70:71], 0
  v_mov_b64 v[72:73], 0
  v_mov_b64 v[74:75], 0
  v_mov_b64 v[76:77], 0
  v_mov_b64 v[78:79], 0
  v_mov_b64 v[80:81], 0
  v_mov_b64 v[82:83], 0
  v_mov_b64 v[84:85], 0
  v_mov_b64 v[86:87], 0
  v_mov_b64 v[88:89], 0
  v_mov_b64 v[90:91], 0
  v_mov_b64 v[92:93], 0
  v_mov_b64 v[94:95], 0
  s_cmp_lg_u32 s63, 0
  s_branch L_k0r
L_k1:
  v_lshlrev_b32 v48, 16, v12
  v_pk_fma_f32 v[28:29], v[96:97], v[48:49], v[28:29] op_sel_hi:[1,0,1]
  v_pk_fma_f32 v[30:31], v[98:99], v[48:49], v[30:31] op_sel_hi:[1,0,1]
  v_and_b32 v50, 0xffff0000, v12
  v_pk_fma_f32 v[28:29], v[100:101], v[50:51], v[28:29] op_sel_hi:[1,0,1]
  v_pk_fma_f32 v[30:31], v[102:103], v[50:51], v[30:31] op_sel_hi:[1,0,1]
  v_lshlrev_b32 v48, 16, v13
  v_pk_fma_f32 v[28:29], v[104:105], v[48:49], v[28:29] op_sel_hi:[1,0,1]
  v_pk_fma_f32 v[30:31], v[106:107], v[48:49], v[30:31] op_sel_hi:[1,0,1]
  v_and_b32 v50, 0xffff0000, v13
  v_pk_fma_f32 v[28:29], v[108:109], v[50:51], v[28:29] op_sel_hi:[1,0,1]
  v_pk_fma_f32 v[30:31], v[110:111], v[50:51], v[30:31] op_sel_hi:[1,0,1]
  v_lshlrev_b32 v48, 16, v14
  v_pk_fma_f32 v[28:29], v[112:113], v[48:49], v[28:29] op_sel_hi:[1,0,1]
  v_pk_fma_f32 v[30:31], v[114:115], v[48:49], v[30:31] op_sel_hi:[1,0,1]
  v_and_b32 v50, 0xffff0000, v14
  v_pk_fma_f32 v[28:29], v[116:117], v[50:51], v[28:29] op_sel_hi:[1,0,1]
  v_pk_fma_f32 v[30:31], v[118:119], v[50:51], v[30:31] op_sel_hi:[1,0,1]
  v_lshlrev_b32 v48, 16, v15
  v_pk_fma_f32 v[28:29], v[120:121], v[48:49], v[28:29] op_sel_hi:[1,0,1]
  v_pk_fma_f32 v[30:31], v[122:123], v[48:49], v[30:31] op_sel_hi:[1,0,1]
  v_and_b32 v50, 0xffff0000, v15
  v_pk_fma_f32 v[28:29], v[124:125], v[50:51], v[28:29] op_sel_hi:[1,0,1]
  v_pk_fma_f32 v[30:31], v[126:127], v[50:51], v[30:31] op_sel_hi:[1,0,1]
  v_mov_b64 v[96:97], 0
  v_mov_b64 v[98:99], 0
  v_mov_b64 v[100:101], 0
  v_mov_b64 v[102:103], 0
  v_mov_b64 v[104:105], 0
  v_mov_b64 v[106:107], 0
  v_mov_b64 v[108:109], 0
  v_mov_b64 v[110:111], 0
  v_mov_b64 v[112:113], 0
  v_mov_b64 v[114:115], 0
  v_mov_b64 v[116:117], 0
  v_mov_b64 v[118:119], 0
  v_mov_b64 v[120:121], 0
  v_mov_b64 v[122:123], 0
  v_mov_b64 v[124:125], 0
  v_mov_b64 v[126:127], 0
  v_add_f32_dpp v28, v28, v28 row_ror:8 row_mask:0xf bank_mask:0xf
  v_add_f32_dpp v29, v29, v29 row_ror:8 row_mask:0xf bank_mask:0xf
  v_add_f32_dpp v30, v30, v30 row_ror:8 row_mask:0xf bank_mask:0xf
  v_add_f32_dpp v31, v31, v31 row_ror:8 row_mask:0xf bank_mask:0xf
  v_add_f32_dpp v28, v28, v28 row_ror:4 row_mask:0xf bank_mask:0xf
  v_add_f32_dpp v29, v29, v29 row_ror:4 row_mask:0xf bank_mask:0xf
  v_add_f32_dpp v30, v30, v30 row_ror:4 row_mask:0xf bank_mask:0xf
  v_add_f32_dpp v31, v31, v31 row_ror:4 row_mask:0xf bank_mask:0xf
  v_add_f32_dpp v28, v28, v28 row_ror:2 row_mask:0xf bank_mask:0xf
  v_add_f32_dpp v29, v29, v29 row_ror:2 row_mask:0xf bank_mask:0xf
  v_add_f32_dpp v30, v30, v30 row_ror:2 row_mask:0xf bank_mask:0xf
  v_add_f32_dpp v31, v31, v31 row_ror:2 row_mask:0xf bank_mask:0xf
  v_add_f32_dpp v28, v28, v28 row_ror:1 row_mask:0xf bank_mask:0xf
  v_add_f32_dpp v29, v29, v29 row_ror:1 row_mask:0xf bank_mask:0xf
  v_add_f32_dpp v30, v30, v30 row_ror:1 row_mask:0xf bank_mask:0xf
  v_add_f32_dpp v31, v31, v31 row_ror:1 row_mask:0xf bank_mask:0xf
  ds_write_b128 v7, v[28:31] offset:1024
  s_waitcnt lgkmcnt(0)
  s_barrier
  s_branch L_k1r
L_b2:
  s_barrier
  s_branch L_loop
L_empty0:
  s_barrier
  ds_read_b128 v[24:27], v7 offset:1088
  ds_read_b64 v[60:61], v52 offset:0
  ds_read_b64 v[62:63], v52 offset:512
  s_mov_b32 s63, 1
  s_branch L_go0
L_last0:
  s_mov_b32 s63, 2
  s_waitcnt vmcnt(8) lgkmcnt(0)
  s_branch L_go0
L_x00:
  v_mfma_f32_16x16x32_bf16 v[92:95], v[56:59], v[44:47], v[92:95]
  s_cmp_eq_u32 s63, 1
  s_cbranch_scc0 L_y00
  s_waitcnt vmcnt(17)
  s_branch L_h10
L_y00:
  s_call_b64 s[44:45], L_epi0
  s_waitcnt vmcnt(0)
  buffer_store_dwordx2 v[28:29], v52, s[40:43], s24 offen sc1
  s_branch L_h10
L_x10:
  v_mfma_f32_16x16x32_bf16 v[124:127], v[56:59], v[44:47], v[124:127]
  s_cmp_eq_u32 s63, 1
  s_cbranch_scc1 L_slot1
  s_branch L_vepi
L_empty1:
  s_barrier
  ds_read_b128 v[24:27], v7 offset:1088
  ds_read_b64 v[60:61], v52 offset:0
  ds_read_b64 v[62:63], v52 offset:512
  s_mov_b32 s63, 1
  s_branch L_go1
L_last1:
  s_mov_b32 s63, 2
  s_waitcnt vmcnt(8) lgkmcnt(0)
  s_branch L_go1
L_x01:
  v_mfma_f32_16x16x32_bf16 v[92:95], v[56:59], v[44:47], v[92:95]
  s_cmp_eq_u32 s63, 1
  s_cbranch_scc0 L_y01
  s_waitcnt vmcnt(17)
  s_branch L_h11
L_y01:
  s_call_b64 s[44:45], L_epi0
  s_waitcnt vmcnt(0)
  buffer_store_dwordx2 v[28:29], v52, s[40:43], s24 offen sc1
  s_branch L_h11
L_x11:
  v_mfma_f32_16x16x32_bf16 v[124:127], v[56:59], v[44:47], v[124:127]
  s_cmp_eq_u32 s63, 1
  s_cbranch_scc1 L_slot0
L_vepi:
  v_pk_mul_f32 v[96:97], v[96:97], v[24:25]
  v_pk_mul_f32 v[100:101], v[100:101], v[24:25]
  v_pk_mul_f32 v[104:105], v[104:105], v[24:25]
  v_pk_mul_f32 v[108:109], v[108:109], v[24:25]
  v_pk_mul_f32 v[112:113], v[112:113], v[24:25]
  v_pk_mul_f32 v[116:117], v[116:117], v[24:25]
  v_pk_mul_f32 v[120:121], v[120:121], v[24:25]
  v_pk_mul_f32 v[124:125], v[124:125], v[24:25]
  v_pk_fma_f32 v[96:97], v[98:99], v[26:27], v[96:97]
  v_pk_fma_f32 v[100:101], v[102:103], v[26:27], v[100:101]
  v_pk_fma_f32 v[104:105], v[106:107], v[26:27], v[104:105]
  v_pk_fma_f32 v[108:109], v[110:111], v[26:27], v[108:109]
  v_pk_fma_f32 v[112:113], v[114:115], v[26:27], v[112:113]
  v_pk_fma_f32 v[116:117], v[118:119], v[26:27], v[116:117]
  v_pk_fma_f32 v[120:121], v[122:123], v[26:27], v[120:121]
  v_pk_fma_f32 v[124:125], v[126:127], v[26:27], v[124:125]
  v_add_f32 v96, v96, v97
  v_add_f32 v112, v112, v113
  v_add_f32 v100, v100, v101
  v_add_f32 v116, v116, v117
  v_add_f32 v104, v104, v105
  v_add_f32 v120, v120, v121
  v_add_f32 v108, v108, v109
  v_add_f32 v124, v124, v125
  v_permlane32_swap_b32 v96, v112
  v_permlane32_swap_b32 v100, v116
  v_permlane32_swap_b32 v104, v120
  v_permlane32_swap_b32 v108, v124
  v_add_f32 v96, v96, v112
  v_add_f32 v104, v104, v120
  v_add_f32 v100, v100, v116
  v_add_f32 v108, v108, v124
  v_permlane16_swap_b32 v96, v104
  s_nop 0
  v_permlane16_swap_b32 v100, v108
  v_add_f32 v30, v96, v104
  v_add_f32 v31, v100, v108
  v_and_or_b32 v30, v30, -2, v62
  v_and_or_b32 v31, v31, -2, v63
  buffer_store_dwordx2 v[30:31], v52, s[40:43], s24 offen offset:512 sc1
  s_barrier
  s_endpgm
L_epi0:
  v_pk_mul_f32 v[64:65], v[64:65], v[24:25]
  v_pk_mul_f32 v[68:69], v[68:69], v[24:25]
  v_pk_mul_f32 v[72:73], v[72:73], v[24:25]
  v_pk_mul_f32 v[76:77], v[76:77], v[24:25]
  v_pk_mul_f32 v[80:81], v[80:81], v[24:25]
  v_pk_mul_f32 v[84:85], v[84:85], v[24:25]
  v_pk_mul_f32 v[88:89], v[88:89], v[24:25]
  v_pk_mul_f32 v[92:93], v[92:93], v[24:25]
  v_pk_fma_f32 v[64:65], v[66:67], v[26:27], v[64:65]
  v_pk_fma_f32 v[68:69], v[70:71], v[26:27], v[68:69]
  v_pk_fma_f32 v[72:73], v[74:75], v[26:27], v[72:73]
  v_pk_fma_f32 v[76:77], v[78:79], v[26:27], v[76:77]
  v_pk_fma_f32 v[80:81], v[82:83], v[26:27], v[80:81]
  v_pk_fma_f32 v[84:85], v[86:87], v[26:27], v[84:85]
  v_pk_fma_f32 v[88:89], v[90:91], v[26:27], v[88:89]
  v_pk_fma_f32 v[92:93], v[94:95], v[26:27], v[92:93]
  v_add_f32 v64, v64, v65
  v_add_f32 v80, v80, v81
  v_add_f32 v68, v68, v69
  v_add_f32 v84, v84, v85
  v_add_f32 v72, v72, v73
  v_add_f32 v88, v88, v89
  v_add_f32 v76, v76, v77
  v_add_f32 v92, v92, v93
  v_permlane32_swap_b32 v64, v80
  v_permlane32_swap_b32 v68, v84
  v_permlane32_swap_b32 v72, v88
  v_permlane32_swap_b32 v76, v92
  v_add_f32 v64, v64, v80
  v_add_f32 v72, v72, v88
  v_add_f32 v68, v68, v84
  v_add_f32 v76, v76, v92
  v_permlane16_swap_b32 v64, v72
  s_nop 0
  v_permlane16_swap_b32 v68, v76
  v_add_f32 v28, v64, v72
  v_add_f32 v29, v68, v76
  v_and_or_b32 v28, v28, -2, v60
  v_and_or_b32 v29, v29, -2, v61
  s_cmp_lg_u32 s63, 0
  s_setpc_b64 s[44:45]
L_helper:
  s_cmp_ge_u32 s54, 16
  s_cselect_b32 s28, s12, s10
  s_cselect_b32 s29, s13, s11
  s_and_b32 s3, s54, 15
  s_lshl_b32 s3, s3, 14
  s_and_b32 s32, s2, 7
  s_lshl_b32 s32, s32, 9
  s_add_u32 s3, s3, s32
  buffer_load_dwordx4 v[32:35], v1, s[28:31], s3 offen
  buffer_load_dwordx4 v[36:39], v1, s[28:31], s3 offen offset:256
  s_mov_b32 s40, s18
  s_mov_b32 s41, s19
  v_lshlrev_b32 v8, 4, v4
  s_add_u32 s35, s24, 0x1000
  s_lshl_b32 s27, s54, 2
  s_add_u32 s48, s16, s27
  s_addc_u32 s49, s17, 0
  buffer_load_dwordx4 v[160:163], v8, s[40:43], s24 offen sc1
  v_lshrrev_b32 v13, 3, v4
  v_and_b32 v14, 7, v4
  v_lshlrev_b32 v14, 4, v14
  v_lshl_add_u32 v13, v13, 10, v14
  s_lshl_b32 s35, s54, 13
  s_lshl_b32 s3, s55, 7
  s_add_u32 s35, s35, s3
  s_add_u32 s35, s35, 65536
  buffer_load_dwordx4 v[164:167], v13, s[40:43], s35 offen sc1
  s_cmp_lg_u32 s55, 0
  s_cbranch_scc1 L_hq
  v_mov_b32 v16, -1
  v_mov_b32 v17, -1
  v_mov_b32 v18, -1
  v_mov_b32 v19, -1
  buffer_store_dwordx4 v[16:19], v8, s[40:43], s26 offen sc1
  s_mov_b32 s67, 1
  s_waitcnt vmcnt(0)
  s_atomic_add s67, s[48:49], 0
L_hq:
  v_lshlrev_b32 v9, 2, v5
  s_mov_b32 s44, s14
  s_mov_b32 s45, s15
  s_mov_b32 s46, 0x4000
  s_mov_b32 s47, 0x20000
  s_lshl_b32 s25, s55, 7
  s_add_u32 s25, s25, s26
  v_lshrrev_b32 v10, 3, v4
  v_and_b32 v11, 7, v4
  v_lshlrev_b32 v11, 3, v11
  v_lshl_add_u32 v10, v10, 7, v11
  s_waitcnt vmcnt(0)
  v_bfi_b32 v160, v160, 0, 1
  v_bfi_b32 v161, v161, 0, 1
  v_bfi_b32 v162, v162, 0, 1
  v_bfi_b32 v163, v163, 0, 1
  v_bfi_b32 v164, v164, 0, 1
  v_bfi_b32 v165, v165, 0, 1
  v_bfi_b32 v166, v166, 0, 1
  v_bfi_b32 v167, v167, 0, 1
  ds_write_b128 v8, v[160:163] offset:0
  s_waitcnt lgkmcnt(0)
  s_barrier
  s_load_dword s34, s[48:49], 0
  ds_read_b32 v12, v9 offset:1024
  s_mov_b32 s66, 0
  s_waitcnt lgkmcnt(0)
  v_min_u32 v12, -2, v12
L_h1a:
  s_cmp_lg_u32 s34, 0
  s_cbranch_scc1 L_h1ago
  s_sleep 16
  s_atomic_add s34, s[48:49], 0 glc
  s_add_u32 s66, s66, 1
  s_cmp_lt_u32 s66, 0x100000
  s_waitcnt lgkmcnt(0)
  s_cbranch_scc1 L_h1a
L_h1ago:
  s_mov_b64 exec, 0xffff
  buffer_store_dword v12, v9, s[40:43], s25 offen sc1
  s_mov_b64 exec, -1
  s_barrier
  s_mov_b32 s66, 0
  s_branch L_h2a
L_h2:
  s_sleep 8
L_h2a:
  buffer_load_dwordx2 v[20:21], v10, s[40:43], s26 offen sc1
  s_add_u32 s66, s66, 1
  s_cmp_ge_u32 s66, 0x100000
  s_waitcnt vmcnt(0)
  s_cbranch_scc1 L_h2go
  v_max_u32 v22, v20, v21
  v_cmp_eq_u32 vcc, -1, v22
  s_cbranch_vccnz L_h2
L_h2go:
  s_nop 1
  v_add_f32_dpp v20, v20, v20 row_ror:8 row_mask:0xf bank_mask:0xf
  v_add_f32_dpp v21, v21, v21 row_ror:8 row_mask:0xf bank_mask:0xf
  v_mov_b32 v22, v20
  v_mov_b32 v23, v21
  s_nop 1
  v_permlane16_swap_b32 v20, v22
  v_permlane16_swap_b32 v21, v23
  v_add_f32 v20, v20, v22
  v_add_f32 v21, v21, v23
  v_mov_b32 v22, v20
  v_mov_b32 v23, v21
  s_nop 1
  v_permlane32_swap_b32 v20, v22
  v_permlane32_swap_b32 v21, v23
  v_add_f32 v20, v20, v22
  v_add_f32 v21, v21, v23
  v_mul_f32 v20, 0x3db8aa3b, v20
  v_mul_f32 v21, 0x3db8aa3b, v21
  v_max_f32 v22, v20, v21
  s_nop 1
  v_max_f32_dpp v22, v22, v22 row_ror:4 row_mask:0xf bank_mask:0xf
  s_nop 1
  v_max_f32_dpp v22, v22, v22 row_ror:2 row_mask:0xf bank_mask:0xf
  s_nop 1
  v_max_f32_dpp v22, v22, v22 row_ror:1 row_mask:0xf bank_mask:0xf
  v_sub_f32 v20, v20, v22
  v_sub_f32 v21, v21, v22
  v_exp_f32 v20, v20
  v_exp_f32 v21, v21
  s_nop 0
  v_add_f32 v22, v20, v21
  s_nop 1
  v_add_f32_dpp v22, v22, v22 row_ror:4 row_mask:0xf bank_mask:0xf
  s_nop 1
  v_add_f32_dpp v22, v22, v22 row_ror:2 row_mask:0xf bank_mask:0xf
  s_nop 1
  v_add_f32_dpp v22, v22, v22 row_ror:1 row_mask:0xf bank_mask:0xf
  v_rcp_f32 v22, v22
  s_nop 0
  v_mul_f32 v20, v20, v22
  v_mul_f32 v21, v21, v22
  s_mov_b64 exec, 0xff
  ds_write_b64 v11, v[20:21] offset:1088
  s_mov_b64 exec, -1
  v_and_b32 v9, 7, v4
  v_lshlrev_b32 v9, 3, v9
  v_lshl_add_u32 v9, v6, 1, v9
  s_lshl_b32 s3, s54, 9
  s_lshl_b32 s32, s55, 6
  s_add_u32 s3, s3, s32
  s_mov_b32 s66, 0
  s_waitcnt lgkmcnt(0)
  s_barrier
  s_barrier
  buffer_load_dwordx4 v[64:67], v13, s[40:43], s35 offen sc1
  buffer_load_dwordx4 v[68:71], v13, s[40:43], s35 offen sc1
  buffer_load_dwordx4 v[72:75], v13, s[40:43], s35 offen sc1
  buffer_load_dwordx4 v[76:79], v13, s[40:43], s35 offen sc1
  buffer_load_dwordx4 v[80:83], v13, s[40:43], s35 offen sc1
  buffer_load_dwordx4 v[84:87], v13, s[40:43], s35 offen sc1
L_h3:
  s_waitcnt vmcnt(5)
  v_xor_b32 v20, v64, v164
  v_xor_b32 v21, v65, v165
  v_xor_b32 v22, v66, v166
  v_xor_b32 v23, v67, v167
  buffer_load_dwordx4 v[64:67], v13, s[40:43], s35 offen sc1
  v_or3_b32 v11, v20, v21, v22
  v_or_b32 v11, v11, v23
  v_and_b32 v11, 1, v11
  v_cmp_eq_u32 vcc, 1, v11
  s_cbranch_vccz L_h3go
  s_waitcnt vmcnt(5)
  v_xor_b32 v20, v68, v164
  v_xor_b32 v21, v69, v165
  v_xor_b32 v22, v70, v166
  v_xor_b32 v23, v71, v167
  buffer_load_dwordx4 v[68:71], v13, s[40:43], s35 offen sc1
  v_or3_b32 v11, v20, v21, v22
  v_or_b32 v11, v11, v23
  v_and_b32 v11, 1, v11
  v_cmp_eq_u32 vcc, 1, v11
  s_cbranch_vccz L_h3go
  s_waitcnt vmcnt(5)
  v_xor_b32 v20, v72, v164
  v_xor_b32 v21, v73, v165
  v_xor_b32 v22, v74, v166
  v_xor_b32 v23, v75, v167
  buffer_load_dwordx4 v[72:75], v13, s[40:43], s35 offen sc1
  v_or3_b32 v11, v20, v21, v22
  v_or_b32 v11, v11, v23
  v_and_b32 v11, 1, v11
  v_cmp_eq_u32 vcc, 1, v11
  s_cbranch_vccz L_h3go
  s_waitcnt vmcnt(5)
  v_xor_b32 v20, v76, v164
  v_xor_b32 v21, v77, v165
  v_xor_b32 v22, v78, v166
  v_xor_b32 v23, v79, v167
  buffer_load_dwordx4 v[76:79], v13, s[40:43], s35 offen sc1
  v_or3_b32 v11, v20, v21, v22
  v_or_b32 v11, v11, v23
  v_and_b32 v11, 1, v11
  v_cmp_eq_u32 vcc, 1, v11
  s_cbranch_vccz L_h3go
  s_waitcnt vmcnt(5)
  v_xor_b32 v20, v80, v164
  v_xor_b32 v21, v81, v165
  v_xor_b32 v22, v82, v166
  v_xor_b32 v23, v83, v167
  buffer_load_dwordx4 v[80:83], v13, s[40:43], s35 offen sc1
  v_or3_b32 v11, v20, v21, v22
  v_or_b32 v11, v11, v23
  v_and_b32 v11, 1, v11
  v_cmp_eq_u32 vcc, 1, v11
  s_cbranch_vccz L_h3go
  s_waitcnt vmcnt(5)
  v_xor_b32 v20, v84, v164
  v_xor_b32 v21, v85, v165
  v_xor_b32 v22, v86, v166
  v_xor_b32 v23, v87, v167
  buffer_load_dwordx4 v[84:87], v13, s[40:43], s35 offen sc1
  v_or3_b32 v11, v20, v21, v22
  v_or_b32 v11, v11, v23
  v_and_b32 v11, 1, v11
  v_cmp_eq_u32 vcc, 1, v11
  s_cbranch_vccz L_h3go
  s_add_u32 s66, s66, 1
  s_cmp_lt_u32 s66, 0x200000
  s_cbranch_scc1 L_h3
L_h3go:
  v_permlane32_swap_b32 v20, v22
  v_permlane32_swap_b32 v21, v23
  v_add_f32 v20, v20, v22
  v_add_f32 v21, v21, v23
  s_nop 1
  v_permlane16_swap_b32 v20, v21
  v_add_f32 v20, v20, v21
  s_nop 1
  v_add_f32_dpp v20, v20, v20 row_ror:8 row_mask:0xf bank_mask:0xf
  v_cvt_pk_bf16_f32 v20, v20, v20
  s_mov_b32 exec_lo, 0x00ff00ff
  s_mov_b32 exec_hi, 0x00ff00ff
  buffer_store_short v20, v9, s[44:47], s3 offen sc1
  s_mov_b64 exec, -1
L_end:
  s_endpgm
.section .rodata,"a"
.p2align 6
.amdhsa_kernel standalone__low_rank_proj_linformer__decode_kernel
  .amdhsa_next_free_vgpr 256
  .amdhsa_next_free_sgpr 72
  .amdhsa_accum_offset 256
  .amdhsa_group_segment_fixed_size 0
  .amdhsa_kernarg_size 64
  .amdhsa_user_sgpr_count 2
  .amdhsa_user_sgpr_kernarg_segment_ptr 1
  .amdhsa_system_sgpr_workgroup_id_x 1
.end_amdhsa_kernel
```
